```python
import torch

def _softmax(x, axis=-1):
    return torch.softmax(x, dim=axis)
def _gelu(x):
    return torch.nn.functional.gelu(x, approximate="tanh")
def _silu(x):
    return torch.nn.functional.silu(x)
def _sigmoid(x):
    return torch.sigmoid(x)
def _layernorm(x, axis=-1, eps=1e-5):
    m = x.mean(dim=axis, keepdim=True)
    v = x.var(dim=axis, keepdim=True, unbiased=False)
    return (x - m) / torch.sqrt(v + eps)
def _scatter_add(tgt, idx, src, axis=0):
    return tgt.clone().index_add_(axis, idx, src)
def _segment_sum(src, seg, n):
    out = torch.zeros((n,) + src.shape[1:], dtype=src.dtype)
    return out.index_add_(0, seg, src)
def _pad(x, pw):
    flat = tuple(v for pair in reversed(pw) for v in pair)
    return torch.nn.functional.pad(x, flat)

kernel_name = 'standalone__softmax_full_bidir__sampling'

def setup_inputs():

    _w = (lambda a: (lambda t: t.to(torch.bfloat16) if t.is_floating_point() else t)(torch.as_tensor(a)))
    B, H, Sq, Skv, Dh = 16, 32, 1, 2048, 128
    return {
        "q": _w((lambda *s: torch.randn(*s, dtype=torch.bfloat16) * 0.8)(B, H, Sq, Dh)),
        "k": _w((lambda *s: torch.randn(*s, dtype=torch.bfloat16) * 0.8)(B, H, Skv, Dh)),
        "v": _w((lambda *s: torch.randn(*s, dtype=torch.bfloat16) * 0.05)(B, H, Skv, Dh)),
    }

def reference(q, k, v):
    scale = q.shape[-1] ** -0.5
    scores = torch.einsum('bhqd,bhkd->bhqk', q, k) * scale
    attn = _softmax(scores, axis=-1)
    return torch.einsum('bhqk,bhkd->bhqd', attn, v)
```

```asm
; @launch grid=(256,1,1) block=(128,1,1) lds=90000
.amdgcn_target "amdgcn-amd-amdhsa--gfx950"
.text
.globl standalone__softmax_full_bidir__sampling_kernel
.p2align 8
.type standalone__softmax_full_bidir__sampling_kernel,@function
standalone__softmax_full_bidir__sampling_kernel:
    s_cmp_ge_u32 s2, 256
    s_cbranch_scc1 L_done
    s_load_dwordx4 s[4:7], s[0:1], 0
    s_load_dwordx4 s[12:15], s[0:1], 16
    s_load_dwordx2 s[70:71], s[0:1], 32
    v_lshrrev_b32 v2, 6, v0
    v_and_b32 v0, 63, v0
    v_readfirstlane_b32 s25, v2
    v_and_b32 v3, 3, v0
    v_lshrrev_b32 v2, 4, v0
    v_lshlrev_b32 v2, 6, v2
    v_lshl_add_u32 v3, v3, 4, v2
    v_bfe_u32 v41, v0, 2, 2
    v_lshl_add_u32 v40, v41, 8, v3
    s_bfe_u32 s35, s25, 0x10000
    s_lshl_b32 s35, s35, 16
    v_add_u32 v40, s35, v40
    v_mov_b32 v44, v40
    s_and_b32 s33, s2, 0x1
    s_bfe_u32 s32, s2, 0x10006
    s_lshl_b32 s32, s32, 1
    s_or_b32 s33, s33, s32
    s_bfe_u32 s32, s2, 0x10005
    s_lshl_b32 s32, s32, 2
    s_or_b32 s33, s33, s32
    s_and_b32 s32, s2, 0x18
    s_or_b32 s33, s33, s32
    s_bfe_u32 s32, s2, 0x10007
    s_lshl_b32 s32, s32, 5
    s_or_b32 s33, s33, s32
    s_bfe_u32 s32, s2, 0x10001
    s_lshl_b32 s32, s32, 6
    s_or_b32 s33, s33, s32
    s_bfe_u32 s32, s2, 0x10002
    s_lshl_b32 s32, s32, 8
    s_or_b32 s33, s33, s32
    s_bfe_u32 s24, s2, 0x10003
    s_lshl_b32 s24, s24, 12
    s_bfe_u32 s32, s2, 0x10004
    s_lshl_b32 s32, s32, 14
    s_or_b32 s24, s24, s32
    s_bfe_u32 s32, s2, 0x10000
    s_lshl_b32 s32, s32, 15
    s_or_b32 s24, s24, s32
    s_bfe_u32 s32, s2, 0x10007
    s_lshl_b32 s32, s32, 18
    s_or_b32 s24, s24, s32
    s_lshl_b32 s32, s33, 19
    s_lshl_b32 s3, s33, 8
    s_lshr_b32 s33, s33, 13
    s_mov_b32 s10, 524288
    s_mov_b32 s11, 0x20000
    s_mov_b32 s18, 131072
    s_mov_b32 s19, 0x20000
    s_waitcnt lgkmcnt(0)
    s_mov_b32 s16, s4
    s_mov_b32 s17, s5
    s_add_u32 s8, s6, s32
    s_addc_u32 s9, s7, s33
    buffer_load_dwordx4 v[28:31], v3, s[16:19], s3 offen
    s_mov_b32 s27, s24
    buffer_load_dwordx4 a[0:3], v44, s[8:11], s24 offen offset:0 nt
    buffer_load_dwordx4 a[4:7], v44, s[8:11], s24 offen offset:1024 nt
    buffer_load_dwordx4 a[8:11], v44, s[8:11], s24 offen offset:2048 nt
    buffer_load_dwordx4 a[12:15], v44, s[8:11], s24 offen offset:3072 nt
    s_or_b32 s24, s24, 0x10000
    s_add_u32 s24, s24, 4096
    s_and_b32 s24, s24, 0x6f000
    buffer_load_dwordx4 a[16:19], v44, s[8:11], s24 offen offset:0 nt
    buffer_load_dwordx4 a[20:23], v44, s[8:11], s24 offen offset:1024 nt
    buffer_load_dwordx4 a[24:27], v44, s[8:11], s24 offen offset:2048 nt
    buffer_load_dwordx4 a[28:31], v44, s[8:11], s24 offen offset:3072 nt
    s_or_b32 s24, s24, 0x10000
    s_add_u32 s24, s24, 4096
    s_and_b32 s24, s24, 0x6f000
    buffer_load_dwordx4 a[32:35], v44, s[8:11], s24 offen offset:0 nt
    buffer_load_dwordx4 a[36:39], v44, s[8:11], s24 offen offset:1024 nt
    buffer_load_dwordx4 a[40:43], v44, s[8:11], s24 offen offset:2048 nt
    buffer_load_dwordx4 a[44:47], v44, s[8:11], s24 offen offset:3072 nt
    s_or_b32 s24, s24, 0x10000
    s_add_u32 s24, s24, 4096
    s_and_b32 s24, s24, 0x6f000
    buffer_load_dwordx4 a[48:51], v44, s[8:11], s24 offen offset:0 nt
    buffer_load_dwordx4 a[52:55], v44, s[8:11], s24 offen offset:1024 nt
    buffer_load_dwordx4 a[56:59], v44, s[8:11], s24 offen offset:2048 nt
    buffer_load_dwordx4 a[60:63], v44, s[8:11], s24 offen offset:3072 nt
    s_or_b32 s24, s24, 0x10000
    s_add_u32 s24, s24, 4096
    s_and_b32 s24, s24, 0x6f000
    s_mov_b32 s43, s27
    s_add_u32 s34, s3, 32768
    buffer_load_dwordx4 v[36:39], v3, s[16:19], s34 offen
    s_add_u32 s28, s12, s32
    s_addc_u32 s29, s13, s33
    s_add_u32 s30, s8, 0x4000000
    s_addc_u32 s31, s9, 0
    s_add_u32 s62, s28, 0x4000000
    s_addc_u32 s63, s29, 0
    s_mov_b32 s20, s14
    s_mov_b32 s21, s15
    s_mov_b32 s22, 131072
    s_mov_b32 s23, 0x20000
    s_mov_b32 s26, 0x3fb8aa3b
    s_mov_b32 s36, 0
    s_mov_b32 s37, 0
    s_getreg_b32 s80, hwreg(HW_REG_XCC_ID, 0, 3)
    s_lshl_b32 s80, s80, 5
    v_and_b32 v45, 7, v0
    v_lshl_add_u32 v45, v45, 2, s80
    v_mov_b32 v43, 0
    s_bfe_u32 s81, s2, 0x50003
    s_add_u32 s81, s81, s80
    v_mov_b32 v46, s81
    s_mov_b32 s86, 36
    s_mov_b32 s82, s86
    s_mov_b32 s83, 64
    v_and_b32 v1, 15, v0
    v_lshlrev_b32 v1, 4, v1
    v_bfe_u32 v2, v0, 4, 1
    v_lshl_add_u32 v1, v2, 8, v1
    v_bfe_u32 v2, v0, 5, 1
    v_lshl_add_u32 v1, v2, 9, v1
    v_add_u32 v1, s35, v1
    v_and_b32 v2, 1, v0
    v_lshlrev_b32 v2, 4, v2
    v_mov_b32 v5, 0xffff
    v_lshlrev_b32 v5, v2, v5
    v_bfe_u32 v2, v0, 1, 2
    v_cmp_eq_u32 vcc, 0, v2
    s_nop 1
    v_cndmask_b32 v8, 0, v5, vcc
    v_cmp_eq_u32 vcc, 1, v2
    s_nop 1
    v_cndmask_b32 v9, 0, v5, vcc
    v_cmp_eq_u32 vcc, 2, v2
    s_nop 1
    v_cndmask_b32 v10, 0, v5, vcc
    v_cmp_eq_u32 vcc, 3, v2
    s_nop 1
    v_cndmask_b32 v11, 0, v5, vcc
    s_waitcnt vmcnt(17)
L_head:
    v_cmp_eq_u32 vcc, 0, v41
    s_nop 1
    v_cndmask_b32 v12, 0, v28, vcc
    v_cndmask_b32 v13, 0, v29, vcc
    v_cndmask_b32 v14, 0, v30, vcc
    v_cndmask_b32 v15, 0, v31, vcc
    v_cmp_eq_u32 vcc, 1, v41
    s_nop 1
    v_cndmask_b32 v16, 0, v28, vcc
    v_cndmask_b32 v17, 0, v29, vcc
    v_cndmask_b32 v18, 0, v30, vcc
    v_cndmask_b32 v19, 0, v31, vcc
    v_cmp_eq_u32 vcc, 2, v41
    s_nop 1
    v_cndmask_b32 v20, 0, v28, vcc
    v_cndmask_b32 v21, 0, v29, vcc
    v_cndmask_b32 v22, 0, v30, vcc
    v_cndmask_b32 v23, 0, v31, vcc
    v_cmp_eq_u32 vcc, 3, v41
    s_nop 1
    v_cndmask_b32 v24, 0, v28, vcc
    v_cndmask_b32 v25, 0, v29, vcc
    v_cndmask_b32 v26, 0, v30, vcc
    v_cndmask_b32 v27, 0, v31, vcc
    v_mov_b32 v4, 0xff800000
L_k:
L_kmain:
    s_add_u32 s83, s83, s82
    s_cmp_ge_u32 s83, 128
    s_cselect_b32 s84, 128, 0
    s_sub_u32 s83, s83, s84
    s_cmp_lg_u32 s84, 0
    s_cbranch_scc1 L_kfast
    s_waitcnt vmcnt(10)
    v_mfma_f32_16x16x32_bf16 v[28:31], a[0:3], v[12:15], 0
    buffer_load_dwordx4 a[0:3], v44, s[8:11], s24 offen offset:0 nt
    s_waitcnt vmcnt(10)
    v_mfma_f32_16x16x32_bf16 v[28:31], a[4:7], v[16:19], v[28:31]
    buffer_load_dwordx4 a[4:7], v44, s[8:11], s24 offen offset:1024 nt
    s_waitcnt vmcnt(10)
    v_mfma_f32_16x16x32_bf16 v[28:31], a[8:11], v[20:23], v[28:31]
    buffer_load_dwordx4 a[8:11], v44, s[8:11], s24 offen offset:2048 nt
    s_waitcnt vmcnt(10)
    v_mfma_f32_16x16x32_bf16 v[28:31], a[12:15], v[24:27], v[28:31]
    buffer_load_dwordx4 a[12:15], v44, s[8:11], s24 offen offset:3072 nt
    s_or_b32 s24, s24, 0x10000
    s_add_u32 s24, s24, 4096
    s_and_b32 s24, s24, 0x6f000
    s_nop 4
    v_mov_b32_dpp v2, v28 quad_perm:[0,0,0,0] row_mask:0xf bank_mask:0xf
    v_mov_b32_dpp v6, v29 quad_perm:[1,1,1,1] row_mask:0xf bank_mask:0xf
    s_nop 0
    v_add_f32_dpp v2, v30, v2 quad_perm:[2,2,2,2] row_mask:0xf bank_mask:0xf
    v_add_f32_dpp v6, v31, v6 quad_perm:[3,3,3,3] row_mask:0xf bank_mask:0xf
    v_add_f32 v3, v2, v6
    v_cvt_pk_bf16_f32 v3, 0, v3
    v_mul_f32 v3, 0x3db504f3, v3
    v_cvt_pk_bf16_f32 v3, 0, v3
    s_set_gpr_idx_on s37, gpr_idx(DST)
    v_mov_b32 v52, v3
    s_set_gpr_idx_off
    v_max_f32 v4, v4, v3
    s_waitcnt vmcnt(10)
    v_mfma_f32_16x16x32_bf16 v[28:31], a[16:19], v[12:15], 0
    buffer_load_dwordx4 a[16:19], v44, s[8:11], s24 offen offset:0 nt
    s_waitcnt vmcnt(10)
    v_mfma_f32_16x16x32_bf16 v[28:31], a[20:23], v[16:19], v[28:31]
    buffer_load_dwordx4 a[20:23], v44, s[8:11], s24 offen offset:1024 nt
    s_waitcnt vmcnt(10)
    v_mfma_f32_16x16x32_bf16 v[28:31], a[24:27], v[20:23], v[28:31]
    buffer_load_dwordx4 a[24:27], v44, s[8:11], s24 offen offset:2048 nt
    s_waitcnt vmcnt(10)
    v_mfma_f32_16x16x32_bf16 v[28:31], a[28:31], v[24:27], v[28:31]
    buffer_load_dwordx4 a[28:31], v44, s[8:11], s24 offen offset:3072 nt
    s_or_b32 s24, s24, 0x10000
    s_add_u32 s24, s24, 4096
    s_and_b32 s24, s24, 0x6f000
    s_nop 4
    v_mov_b32_dpp v2, v28 quad_perm:[0,0,0,0] row_mask:0xf bank_mask:0xf
    v_mov_b32_dpp v6, v29 quad_perm:[1,1,1,1] row_mask:0xf bank_mask:0xf
    s_nop 0
    v_add_f32_dpp v2, v30, v2 quad_perm:[2,2,2,2] row_mask:0xf bank_mask:0xf
    v_add_f32_dpp v6, v31, v6 quad_perm:[3,3,3,3] row_mask:0xf bank_mask:0xf
    v_add_f32 v3, v2, v6
    v_cvt_pk_bf16_f32 v3, 0, v3
    v_mul_f32 v3, 0x3db504f3, v3
    v_cvt_pk_bf16_f32 v3, 0, v3
    s_set_gpr_idx_on s37, gpr_idx(DST)
    v_mov_b32 v53, v3
    s_set_gpr_idx_off
    v_max_f32 v4, v4, v3
    s_waitcnt vmcnt(10)
    v_mfma_f32_16x16x32_bf16 v[28:31], a[32:35], v[12:15], 0
    buffer_load_dwordx4 a[32:35], v44, s[8:11], s24 offen offset:0 nt
    s_waitcnt vmcnt(10)
    v_mfma_f32_16x16x32_bf16 v[28:31], a[36:39], v[16:19], v[28:31]
    buffer_load_dwordx4 a[36:39], v44, s[8:11], s24 offen offset:1024 nt
    s_waitcnt vmcnt(8)
    v_mfma_f32_16x16x32_bf16 v[28:31], a[40:43], v[20:23], v[28:31]
    buffer_load_dwordx4 a[40:43], v44, s[8:11], s24 offen offset:2048 nt
    s_waitcnt vmcnt(8)
    v_mfma_f32_16x16x32_bf16 v[28:31], a[44:47], v[24:27], v[28:31]
    buffer_load_dwordx4 a[44:47], v44, s[8:11], s24 offen offset:3072 nt
    s_or_b32 s24, s24, 0x10000
    s_add_u32 s24, s24, 4096
    s_and_b32 s24, s24, 0x6f000
    s_nop 4
    v_mov_b32_dpp v2, v28 quad_perm:[0,0,0,0] row_mask:0xf bank_mask:0xf
    v_mov_b32_dpp v6, v29 quad_perm:[1,1,1,1] row_mask:0xf bank_mask:0xf
    s_nop 0
    v_add_f32_dpp v2, v30, v2 quad_perm:[2,2,2,2] row_mask:0xf bank_mask:0xf
    v_add_f32_dpp v6, v31, v6 quad_perm:[3,3,3,3] row_mask:0xf bank_mask:0xf
    v_add_f32 v3, v2, v6
    v_cvt_pk_bf16_f32 v3, 0, v3
    v_mul_f32 v3, 0x3db504f3, v3
    v_cvt_pk_bf16_f32 v3, 0, v3
    s_set_gpr_idx_on s37, gpr_idx(DST)
    v_mov_b32 v54, v3
    s_set_gpr_idx_off
    v_max_f32 v4, v4, v3
    s_waitcnt vmcnt(8)
    v_mfma_f32_16x16x32_bf16 v[28:31], a[48:51], v[12:15], 0
    buffer_load_dwordx4 a[48:51], v44, s[8:11], s24 offen offset:0 nt
    s_waitcnt vmcnt(8)
    v_mfma_f32_16x16x32_bf16 v[28:31], a[52:55], v[16:19], v[28:31]
    buffer_load_dwordx4 a[52:55], v44, s[8:11], s24 offen offset:1024 nt
    s_waitcnt vmcnt(8)
    v_mfma_f32_16x16x32_bf16 v[28:31], a[56:59], v[20:23], v[28:31]
    buffer_load_dwordx4 a[56:59], v44, s[8:11], s24 offen offset:2048 nt
    s_waitcnt vmcnt(8)
    v_mfma_f32_16x16x32_bf16 v[28:31], a[60:63], v[24:27], v[28:31]
    buffer_load_dwordx4 a[60:63], v44, s[8:11], s24 offen offset:3072 nt
    s_or_b32 s24, s24, 0x10000
    s_add_u32 s24, s24, 4096
    s_and_b32 s24, s24, 0x6f000
    s_nop 4
    v_mov_b32_dpp v2, v28 quad_perm:[0,0,0,0] row_mask:0xf bank_mask:0xf
    v_mov_b32_dpp v6, v29 quad_perm:[1,1,1,1] row_mask:0xf bank_mask:0xf
    s_nop 0
    v_add_f32_dpp v2, v30, v2 quad_perm:[2,2,2,2] row_mask:0xf bank_mask:0xf
    v_add_f32_dpp v6, v31, v6 quad_perm:[3,3,3,3] row_mask:0xf bank_mask:0xf
    v_add_f32 v3, v2, v6
    v_cvt_pk_bf16_f32 v3, 0, v3
    v_mul_f32 v3, 0x3db504f3, v3
    v_cvt_pk_bf16_f32 v3, 0, v3
    s_set_gpr_idx_on s37, gpr_idx(DST)
    v_mov_b32 v55, v3
    s_set_gpr_idx_off
    v_max_f32 v4, v4, v3
    s_branch L_ktail
L_kfast:
    s_waitcnt vmcnt(12)
    v_mfma_f32_16x16x32_bf16 v[28:31], a[0:3], v[12:15], 0
    buffer_load_dwordx4 a[0:3], v44, s[8:11], s24 offen offset:0 nt
    s_waitcnt vmcnt(12)
    v_mfma_f32_16x16x32_bf16 v[28:31], a[4:7], v[16:19], v[28:31]
    buffer_load_dwordx4 a[4:7], v44, s[8:11], s24 offen offset:1024 nt
    s_waitcnt vmcnt(12)
    v_mfma_f32_16x16x32_bf16 v[28:31], a[8:11], v[20:23], v[28:31]
    buffer_load_dwordx4 a[8:11], v44, s[8:11], s24 offen offset:2048 nt
    s_waitcnt vmcnt(12)
    v_mfma_f32_16x16x32_bf16 v[28:31], a[12:15], v[24:27], v[28:31]
    buffer_load_dwordx4 a[12:15], v44, s[8:11], s24 offen offset:3072 nt
    s_or_b32 s24, s24, 0x10000
    s_add_u32 s24, s24, 4096
    s_and_b32 s24, s24, 0x6f000
    s_nop 4
    v_mov_b32_dpp v2, v28 quad_perm:[0,0,0,0] row_mask:0xf bank_mask:0xf
    v_mov_b32_dpp v6, v29 quad_perm:[1,1,1,1] row_mask:0xf bank_mask:0xf
    s_nop 0
    v_add_f32_dpp v2, v30, v2 quad_perm:[2,2,2,2] row_mask:0xf bank_mask:0xf
    v_add_f32_dpp v6, v31, v6 quad_perm:[3,3,3,3] row_mask:0xf bank_mask:0xf
    v_add_f32 v3, v2, v6
    v_cvt_pk_bf16_f32 v3, 0, v3
    v_mul_f32 v3, 0x3db504f3, v3
    v_cvt_pk_bf16_f32 v3, 0, v3
    s_set_gpr_idx_on s37, gpr_idx(DST)
    v_mov_b32 v52, v3
    s_set_gpr_idx_off
    v_max_f32 v4, v4, v3
    s_waitcnt vmcnt(12)
    v_mfma_f32_16x16x32_bf16 v[28:31], a[16:19], v[12:15], 0
    buffer_load_dwordx4 a[16:19], v44, s[8:11], s24 offen offset:0 nt
    s_waitcnt vmcnt(12)
    v_mfma_f32_16x16x32_bf16 v[28:31], a[20:23], v[16:19], v[28:31]
    buffer_load_dwordx4 a[20:23], v44, s[8:11], s24 offen offset:1024 nt
    s_waitcnt vmcnt(12)
    v_mfma_f32_16x16x32_bf16 v[28:31], a[24:27], v[20:23], v[28:31]
    buffer_load_dwordx4 a[24:27], v44, s[8:11], s24 offen offset:2048 nt
    s_waitcnt vmcnt(12)
    v_mfma_f32_16x16x32_bf16 v[28:31], a[28:31], v[24:27], v[28:31]
    buffer_load_dwordx4 a[28:31], v44, s[8:11], s24 offen offset:3072 nt
    s_or_b32 s24, s24, 0x10000
    s_add_u32 s24, s24, 4096
    s_and_b32 s24, s24, 0x6f000
    s_nop 4
    v_mov_b32_dpp v2, v28 quad_perm:[0,0,0,0] row_mask:0xf bank_mask:0xf
    v_mov_b32_dpp v6, v29 quad_perm:[1,1,1,1] row_mask:0xf bank_mask:0xf
    s_nop 0
    v_add_f32_dpp v2, v30, v2 quad_perm:[2,2,2,2] row_mask:0xf bank_mask:0xf
    v_add_f32_dpp v6, v31, v6 quad_perm:[3,3,3,3] row_mask:0xf bank_mask:0xf
    v_add_f32 v3, v2, v6
    v_cvt_pk_bf16_f32 v3, 0, v3
    v_mul_f32 v3, 0x3db504f3, v3
    v_cvt_pk_bf16_f32 v3, 0, v3
    s_set_gpr_idx_on s37, gpr_idx(DST)
    v_mov_b32 v53, v3
    s_set_gpr_idx_off
    v_max_f32 v4, v4, v3
    s_waitcnt vmcnt(12)
    v_mfma_f32_16x16x32_bf16 v[28:31], a[32:35], v[12:15], 0
    buffer_load_dwordx4 a[32:35], v44, s[8:11], s24 offen offset:0 nt
    s_waitcnt vmcnt(12)
    v_mfma_f32_16x16x32_bf16 v[28:31], a[36:39], v[16:19], v[28:31]
    buffer_load_dwordx4 a[36:39], v44, s[8:11], s24 offen offset:1024 nt
    s_waitcnt vmcnt(12)
    v_mfma_f32_16x16x32_bf16 v[28:31], a[40:43], v[20:23], v[28:31]
    buffer_load_dwordx4 a[40:43], v44, s[8:11], s24 offen offset:2048 nt
    s_waitcnt vmcnt(12)
    v_mfma_f32_16x16x32_bf16 v[28:31], a[44:47], v[24:27], v[28:31]
    buffer_load_dwordx4 a[44:47], v44, s[8:11], s24 offen offset:3072 nt
    s_or_b32 s24, s24, 0x10000
    s_add_u32 s24, s24, 4096
    s_and_b32 s24, s24, 0x6f000
    s_nop 4
    v_mov_b32_dpp v2, v28 quad_perm:[0,0,0,0] row_mask:0xf bank_mask:0xf
    v_mov_b32_dpp v6, v29 quad_perm:[1,1,1,1] row_mask:0xf bank_mask:0xf
    s_nop 0
    v_add_f32_dpp v2, v30, v2 quad_perm:[2,2,2,2] row_mask:0xf bank_mask:0xf
    v_add_f32_dpp v6, v31, v6 quad_perm:[3,3,3,3] row_mask:0xf bank_mask:0xf
    v_add_f32 v3, v2, v6
    v_cvt_pk_bf16_f32 v3, 0, v3
    v_mul_f32 v3, 0x3db504f3, v3
    v_cvt_pk_bf16_f32 v3, 0, v3
    s_set_gpr_idx_on s37, gpr_idx(DST)
    v_mov_b32 v54, v3
    s_set_gpr_idx_off
    v_max_f32 v4, v4, v3
    s_waitcnt vmcnt(10)
    v_mfma_f32_16x16x32_bf16 v[28:31], a[48:51], v[12:15], 0
    buffer_load_dwordx4 a[48:51], v44, s[8:11], s24 offen offset:0 nt
    s_waitcnt vmcnt(10)
    v_mfma_f32_16x16x32_bf16 v[28:31], a[52:55], v[16:19], v[28:31]
    buffer_load_dwordx4 a[52:55], v44, s[8:11], s24 offen offset:1024 nt
    s_waitcnt vmcnt(10)
    v_mfma_f32_16x16x32_bf16 v[28:31], a[56:59], v[20:23], v[28:31]
    buffer_load_dwordx4 a[56:59], v44, s[8:11], s24 offen offset:2048 nt
    s_waitcnt vmcnt(10)
    v_mfma_f32_16x16x32_bf16 v[28:31], a[60:63], v[24:27], v[28:31]
    buffer_load_dwordx4 a[60:63], v44, s[8:11], s24 offen offset:3072 nt
    s_or_b32 s24, s24, 0x10000
    s_add_u32 s24, s24, 4096
    s_and_b32 s24, s24, 0x6f000
    s_nop 4
    v_mov_b32_dpp v2, v28 quad_perm:[0,0,0,0] row_mask:0xf bank_mask:0xf
    v_mov_b32_dpp v6, v29 quad_perm:[1,1,1,1] row_mask:0xf bank_mask:0xf
    s_nop 0
    v_add_f32_dpp v2, v30, v2 quad_perm:[2,2,2,2] row_mask:0xf bank_mask:0xf
    v_add_f32_dpp v6, v31, v6 quad_perm:[3,3,3,3] row_mask:0xf bank_mask:0xf
    v_add_f32 v3, v2, v6
    v_cvt_pk_bf16_f32 v3, 0, v3
    v_mul_f32 v3, 0x3db504f3, v3
    v_cvt_pk_bf16_f32 v3, 0, v3
    s_set_gpr_idx_on s37, gpr_idx(DST)
    v_mov_b32 v55, v3
    s_set_gpr_idx_off
    v_max_f32 v4, v4, v3
L_ktail:
    s_cmp_ge_u32 s36, 60
    s_cbranch_scc1 L_k_nofb
    v_sad_u8 v42, v43, 0, 0
    s_add_u32 s84, s36, 1
    v_msad_u8 v47, -1, v43, v42
    v_lshl_add_u32 v42, v47, 16, v42
    v_mov_b32 v47, s84
    s_lshl_b32 s84, s36, 5
    v_add_u32_dpp v42, v42, v42 quad_perm:[1,0,3,2] row_mask:0xf bank_mask:0xf
    s_sub_u32 s84, s84, 14
    s_nop 0
    v_add_u32_dpp v42, v42, v42 quad_perm:[2,3,0,1] row_mask:0xf bank_mask:0xf
    s_nop 1
    v_add_u32_dpp v42, v42, v42 row_ror:4 row_mask:0xf bank_mask:0xf
    s_mov_b64 exec, 1
    v_readfirstlane_b32 s81, v42
    global_store_byte v46, v47, s[70:71]
    s_mov_b64 exec, -1
    global_load_dword v43, v45, s[70:71] sc0
    s_lshr_b32 s87, s81, 16
    s_and_b32 s81, s81, 0xffff
    s_mul_i32 s84, s84, s87
    s_mul_i32 s81, s81, 255 * 32
    s_sub_i32 s84, s81, s84
    s_ashr_i32 s84, s84, 8
    s_mul_i32 s84, s84, 32
    s_ashr_i32 s84, s84, 8
    s_add_i32 s84, s84, s86
    s_max_i32 s84, s84, 0
    s_min_i32 s82, s84, 128
L_k_nofb:
    s_add_u32 s40, s36, 2
    s_add_u32 s36, s36, 1
    s_add_u32 s37, s37, 4
    s_and_b32 s40, s40, 14
    s_cbranch_scc1 L_k
    s_bitcmp1_b32 s36, 0
    s_cbranch_scc0 L_kedge
    s_cmp_gt_u32 s36, 16
    s_cbranch_scc1 L_tov
    s_mov_b32 s8, s30
    s_mov_b32 s9, s31
    s_mov_b32 s24, s43
    s_branch L_k
L_tov:
    s_mov_b32 s8, s28
    s_mov_b32 s9, s29
    s_mov_b32 s24, s27
    v_mov_b32 v44, v1
    s_branch L_k
L_kedge:
    s_cmp_gt_u32 s36, 16
    s_cbranch_scc1 L_kdone
    v_mov_b32 v5, v4
    v_mov_b32 v28, v36
    v_mov_b32 v29, v37
    v_mov_b32 v30, v38
    v_mov_b32 v31, v39
    s_branch L_head
L_kdone:
    v_max_f32_dpp v5, v5, v5 row_ror:4 row_mask:0xf bank_mask:0xf
    v_max_f32_dpp v4, v4, v4 row_ror:4 row_mask:0xf bank_mask:0xf
    s_mov_b32 s37, 0
    v_max_f32_dpp v5, v5, v5 row_ror:8 row_mask:0xf bank_mask:0xf
    v_max_f32_dpp v4, v4, v4 row_ror:8 row_mask:0xf bank_mask:0xf
    v_mov_b32 v2, v5
    v_mov_b32 v6, v4
    s_nop 0
    v_permlane16_swap_b32 v2, v5
    v_permlane16_swap_b32 v6, v4
    s_nop 0
    v_max_f32 v5, v5, v2
    v_max_f32 v4, v4, v6
    v_mov_b32 v2, v5
    v_mov_b32 v6, v4
    s_nop 0
    v_permlane32_swap_b32 v2, v5
    v_permlane32_swap_b32 v6, v4
    s_nop 0
    v_max_f32 v5, v5, v2
    v_max_f32 v4, v4, v6
    v_mul_f32 v39, s26, v4
    v_mul_f32 v4, s26, v5
L_vinit:
    v_mov_b32 v5, 0
    v_mov_b32 v28, 0
    v_mov_b32 v29, 0
    v_mov_b32 v30, 0
    v_mov_b32 v31, 0
    v_mov_b32 v32, 0
    v_mov_b32 v33, 0
    v_mov_b32 v34, 0
    v_mov_b32 v35, 0
L_v:
    s_cmp_ge_u32 s36, 61
    s_cbranch_scc1 L_valt0
L_vmain:
    s_add_u32 s83, s83, s82
    s_cmp_ge_u32 s83, 128
    s_cselect_b32 s84, 128, 0
    s_sub_u32 s83, s83, s84
    s_cmp_lg_u32 s84, 0
    s_cbranch_scc1 L_vfast
    s_set_gpr_idx_on s37, gpr_idx(SRC0)
    v_fma_f32 v48, v52, s26, -v4
    v_fma_f32 v49, v53, s26, -v4
    v_fma_f32 v50, v54, s26, -v4
    v_fma_f32 v51, v55, s26, -v4
    s_set_gpr_idx_off
    v_exp_f32 v48, v48
    v_exp_f32 v49, v49
    v_exp_f32 v50, v50
    v_exp_f32 v51, v51
    v_cvt_pk_bf16_f32 v2, v48, v48
    v_add_f32 v5, v5, v48
    v_and_b32 v12, v2, v8
    v_and_b32 v13, v2, v9
    v_and_b32_dpp v14, v2, v10 row_shr:4 row_mask:0xf bank_mask:0xf bound_ctrl:0
    v_and_b32_dpp v15, v2, v11 row_shr:4 row_mask:0xf bank_mask:0xf bound_ctrl:0
    v_and_b32_dpp v16, v2, v8 row_shl:4 row_mask:0xf bank_mask:0xf bound_ctrl:0
    v_and_b32_dpp v17, v2, v9 row_shl:4 row_mask:0xf bank_mask:0xf bound_ctrl:0
    v_and_b32 v18, v2, v10
    v_and_b32 v19, v2, v11
    s_waitcnt vmcnt(10)
    v_mfma_f32_16x16x32_bf16 v[28:31], a[0:3], v[12:15], v[28:31]
    buffer_load_dwordx4 a[0:3], v44, s[8:11], s24 offen offset:0 nt
    s_waitcnt vmcnt(10)
    v_mfma_f32_16x16x32_bf16 v[28:31], a[4:7], v[16:19], v[28:31]
    buffer_load_dwordx4 a[4:7], v44, s[8:11], s24 offen offset:1024 nt
    s_waitcnt vmcnt(10)
    v_mfma_f32_16x16x32_bf16 v[32:35], a[8:11], v[12:15], v[32:35]
    buffer_load_dwordx4 a[8:11], v44, s[8:11], s24 offen offset:2048 nt
    s_waitcnt vmcnt(10)
    v_mfma_f32_16x16x32_bf16 v[32:35], a[12:15], v[16:19], v[32:35]
    buffer_load_dwordx4 a[12:15], v44, s[8:11], s24 offen offset:3072 nt
    s_or_b32 s24, s24, 0x10000
    s_add_u32 s24, s24, 4096
    s_and_b32 s24, s24, 0x6f000
    v_cvt_pk_bf16_f32 v2, v49, v49
    v_add_f32 v5, v5, v49
    v_and_b32 v12, v2, v8
    v_and_b32 v13, v2, v9
    v_and_b32_dpp v14, v2, v10 row_shr:4 row_mask:0xf bank_mask:0xf bound_ctrl:0
    v_and_b32_dpp v15, v2, v11 row_shr:4 row_mask:0xf bank_mask:0xf bound_ctrl:0
    v_and_b32_dpp v16, v2, v8 row_shl:4 row_mask:0xf bank_mask:0xf bound_ctrl:0
    v_and_b32_dpp v17, v2, v9 row_shl:4 row_mask:0xf bank_mask:0xf bound_ctrl:0
    v_and_b32 v18, v2, v10
    v_and_b32 v19, v2, v11
    s_waitcnt vmcnt(10)
    v_mfma_f32_16x16x32_bf16 v[28:31], a[16:19], v[12:15], v[28:31]
    buffer_load_dwordx4 a[16:19], v44, s[8:11], s24 offen offset:0 nt
    s_waitcnt vmcnt(10)
    v_mfma_f32_16x16x32_bf16 v[28:31], a[20:23], v[16:19], v[28:31]
    buffer_load_dwordx4 a[20:23], v44, s[8:11], s24 offen offset:1024 nt
    s_waitcnt vmcnt(10)
    v_mfma_f32_16x16x32_bf16 v[32:35], a[24:27], v[12:15], v[32:35]
    buffer_load_dwordx4 a[24:27], v44, s[8:11], s24 offen offset:2048 nt
    s_waitcnt vmcnt(10)
    v_mfma_f32_16x16x32_bf16 v[32:35], a[28:31], v[16:19], v[32:35]
    buffer_load_dwordx4 a[28:31], v44, s[8:11], s24 offen offset:3072 nt
    s_or_b32 s24, s24, 0x10000
    s_add_u32 s24, s24, 4096
    s_and_b32 s24, s24, 0x6f000
    v_cvt_pk_bf16_f32 v2, v50, v50
    v_add_f32 v5, v5, v50
    v_and_b32 v12, v2, v8
    v_and_b32 v13, v2, v9
    v_and_b32_dpp v14, v2, v10 row_shr:4 row_mask:0xf bank_mask:0xf bound_ctrl:0
    v_and_b32_dpp v15, v2, v11 row_shr:4 row_mask:0xf bank_mask:0xf bound_ctrl:0
    v_and_b32_dpp v16, v2, v8 row_shl:4 row_mask:0xf bank_mask:0xf bound_ctrl:0
    v_and_b32_dpp v17, v2, v9 row_shl:4 row_mask:0xf bank_mask:0xf bound_ctrl:0
    v_and_b32 v18, v2, v10
    v_and_b32 v19, v2, v11
    s_waitcnt vmcnt(10)
    v_mfma_f32_16x16x32_bf16 v[28:31], a[32:35], v[12:15], v[28:31]
    buffer_load_dwordx4 a[32:35], v44, s[8:11], s24 offen offset:0 nt
    s_waitcnt vmcnt(10)
    v_mfma_f32_16x16x32_bf16 v[28:31], a[36:39], v[16:19], v[28:31]
    buffer_load_dwordx4 a[36:39], v44, s[8:11], s24 offen offset:1024 nt
    s_waitcnt vmcnt(8)
    v_mfma_f32_16x16x32_bf16 v[32:35], a[40:43], v[12:15], v[32:35]
    buffer_load_dwordx4 a[40:43], v44, s[8:11], s24 offen offset:2048 nt
    s_waitcnt vmcnt(8)
    v_mfma_f32_16x16x32_bf16 v[32:35], a[44:47], v[16:19], v[32:35]
    buffer_load_dwordx4 a[44:47], v44, s[8:11], s24 offen offset:3072 nt
    s_or_b32 s24, s24, 0x10000
    s_add_u32 s24, s24, 4096
    s_and_b32 s24, s24, 0x6f000
    v_cvt_pk_bf16_f32 v2, v51, v51
    v_add_f32 v5, v5, v51
    v_and_b32 v12, v2, v8
    v_and_b32 v13, v2, v9
    v_and_b32_dpp v14, v2, v10 row_shr:4 row_mask:0xf bank_mask:0xf bound_ctrl:0
    v_and_b32_dpp v15, v2, v11 row_shr:4 row_mask:0xf bank_mask:0xf bound_ctrl:0
    v_and_b32_dpp v16, v2, v8 row_shl:4 row_mask:0xf bank_mask:0xf bound_ctrl:0
    v_and_b32_dpp v17, v2, v9 row_shl:4 row_mask:0xf bank_mask:0xf bound_ctrl:0
    v_and_b32 v18, v2, v10
    v_and_b32 v19, v2, v11
    s_waitcnt vmcnt(8)
    v_mfma_f32_16x16x32_bf16 v[28:31], a[48:51], v[12:15], v[28:31]
    buffer_load_dwordx4 a[48:51], v44, s[8:11], s24 offen offset:0 nt
    s_waitcnt vmcnt(8)
    v_mfma_f32_16x16x32_bf16 v[28:31], a[52:55], v[16:19], v[28:31]
    buffer_load_dwordx4 a[52:55], v44, s[8:11], s24 offen offset:1024 nt
    s_waitcnt vmcnt(8)
    v_mfma_f32_16x16x32_bf16 v[32:35], a[56:59], v[12:15], v[32:35]
    buffer_load_dwordx4 a[56:59], v44, s[8:11], s24 offen offset:2048 nt
    s_waitcnt vmcnt(8)
    v_mfma_f32_16x16x32_bf16 v[32:35], a[60:63], v[16:19], v[32:35]
    buffer_load_dwordx4 a[60:63], v44, s[8:11], s24 offen offset:3072 nt
    s_or_b32 s24, s24, 0x10000
    s_add_u32 s24, s24, 4096
    s_and_b32 s24, s24, 0x6f000
    s_branch L_vtail
L_valt0:
    s_set_gpr_idx_on s37, gpr_idx(SRC0)
    v_fma_f32 v48, v52, s26, -v4
    v_fma_f32 v49, v53, s26, -v4
    v_fma_f32 v50, v54, s26, -v4
    v_fma_f32 v51, v55, s26, -v4
    s_set_gpr_idx_off
    v_exp_f32 v48, v48
    v_exp_f32 v49, v49
    v_exp_f32 v50, v50
    v_exp_f32 v51, v51
    v_cvt_pk_bf16_f32 v2, v48, v48
    v_add_f32 v5, v5, v48
    v_and_b32 v12, v2, v8
    v_and_b32 v13, v2, v9
    v_and_b32_dpp v14, v2, v10 row_shr:4 row_mask:0xf bank_mask:0xf bound_ctrl:0
    v_and_b32_dpp v15, v2, v11 row_shr:4 row_mask:0xf bank_mask:0xf bound_ctrl:0
    v_and_b32_dpp v16, v2, v8 row_shl:4 row_mask:0xf bank_mask:0xf bound_ctrl:0
    v_and_b32_dpp v17, v2, v9 row_shl:4 row_mask:0xf bank_mask:0xf bound_ctrl:0
    v_and_b32 v18, v2, v10
    v_and_b32 v19, v2, v11
    s_waitcnt vmcnt(15)
    v_mfma_f32_16x16x32_bf16 v[28:31], a[0:3], v[12:15], v[28:31]
    buffer_load_dwordx4 a[0:3], v44, s[8:11], s24 offen offset:0 nt
    s_waitcnt vmcnt(15)
    v_mfma_f32_16x16x32_bf16 v[28:31], a[4:7], v[16:19], v[28:31]
    buffer_load_dwordx4 a[4:7], v44, s[8:11], s24 offen offset:1024 nt
    s_waitcnt vmcnt(15)
    v_mfma_f32_16x16x32_bf16 v[32:35], a[8:11], v[12:15], v[32:35]
    buffer_load_dwordx4 a[8:11], v44, s[8:11], s24 offen offset:2048 nt
    s_waitcnt vmcnt(15)
    v_mfma_f32_16x16x32_bf16 v[32:35], a[12:15], v[16:19], v[32:35]
    buffer_load_dwordx4 a[12:15], v44, s[8:11], s24 offen offset:3072 nt
    s_or_b32 s24, s24, 0x10000
    s_add_u32 s24, s24, 4096
    s_and_b32 s24, s24, 0x6f000
    v_cvt_pk_bf16_f32 v2, v49, v49
    v_add_f32 v5, v5, v49
    v_and_b32 v12, v2, v8
    v_and_b32 v13, v2, v9
    v_and_b32_dpp v14, v2, v10 row_shr:4 row_mask:0xf bank_mask:0xf bound_ctrl:0
    v_and_b32_dpp v15, v2, v11 row_shr:4 row_mask:0xf bank_mask:0xf bound_ctrl:0
    v_and_b32_dpp v16, v2, v8 row_shl:4 row_mask:0xf bank_mask:0xf bound_ctrl:0
    v_and_b32_dpp v17, v2, v9 row_shl:4 row_mask:0xf bank_mask:0xf bound_ctrl:0
    v_and_b32 v18, v2, v10
    v_and_b32 v19, v2, v11
    s_waitcnt vmcnt(15)
    v_mfma_f32_16x16x32_bf16 v[28:31], a[16:19], v[12:15], v[28:31]
    buffer_load_dwordx4 a[16:19], v44, s[8:11], s24 offen offset:0 nt
    s_waitcnt vmcnt(15)
    v_mfma_f32_16x16x32_bf16 v[28:31], a[20:23], v[16:19], v[28:31]
    buffer_load_dwordx4 a[20:23], v44, s[8:11], s24 offen offset:1024 nt
    s_waitcnt vmcnt(15)
    v_mfma_f32_16x16x32_bf16 v[32:35], a[24:27], v[12:15], v[32:35]
    buffer_load_dwordx4 a[24:27], v44, s[8:11], s24 offen offset:2048 nt
    s_waitcnt vmcnt(15)
    v_mfma_f32_16x16x32_bf16 v[32:35], a[28:31], v[16:19], v[32:35]
    buffer_load_dwordx4 a[28:31], v44, s[8:11], s24 offen offset:3072 nt
    s_or_b32 s24, s24, 0x10000
    s_add_u32 s24, s24, 4096
    s_and_b32 s24, s24, 0x6f000
    v_cvt_pk_bf16_f32 v2, v50, v50
    v_add_f32 v5, v5, v50
    v_and_b32 v12, v2, v8
    v_and_b32 v13, v2, v9
    v_and_b32_dpp v14, v2, v10 row_shr:4 row_mask:0xf bank_mask:0xf bound_ctrl:0
    v_and_b32_dpp v15, v2, v11 row_shr:4 row_mask:0xf bank_mask:0xf bound_ctrl:0
    v_and_b32_dpp v16, v2, v8 row_shl:4 row_mask:0xf bank_mask:0xf bound_ctrl:0
    v_and_b32_dpp v17, v2, v9 row_shl:4 row_mask:0xf bank_mask:0xf bound_ctrl:0
    v_and_b32 v18, v2, v10
    v_and_b32 v19, v2, v11
    s_waitcnt vmcnt(15)
    v_mfma_f32_16x16x32_bf16 v[28:31], a[32:35], v[12:15], v[28:31]
    buffer_load_dwordx4 a[32:35], v44, s[8:11], s24 offen offset:0 nt
    s_waitcnt vmcnt(15)
    v_mfma_f32_16x16x32_bf16 v[28:31], a[36:39], v[16:19], v[28:31]
    buffer_load_dwordx4 a[36:39], v44, s[8:11], s24 offen offset:1024 nt
    s_waitcnt vmcnt(15)
    v_mfma_f32_16x16x32_bf16 v[32:35], a[40:43], v[12:15], v[32:35]
    buffer_load_dwordx4 a[40:43], v44, s[8:11], s24 offen offset:2048 nt
    s_waitcnt vmcnt(15)
    v_mfma_f32_16x16x32_bf16 v[32:35], a[44:47], v[16:19], v[32:35]
    buffer_load_dwordx4 a[44:47], v44, s[8:11], s24 offen offset:3072 nt
    s_or_b32 s24, s24, 0x10000
    s_add_u32 s24, s24, 4096
    s_and_b32 s24, s24, 0x6f000
    v_cvt_pk_bf16_f32 v2, v51, v51
    v_add_f32 v5, v5, v51
    v_and_b32 v12, v2, v8
    v_and_b32 v13, v2, v9
    v_and_b32_dpp v14, v2, v10 row_shr:4 row_mask:0xf bank_mask:0xf bound_ctrl:0
    v_and_b32_dpp v15, v2, v11 row_shr:4 row_mask:0xf bank_mask:0xf bound_ctrl:0
    v_and_b32_dpp v16, v2, v8 row_shl:4 row_mask:0xf bank_mask:0xf bound_ctrl:0
    v_and_b32_dpp v17, v2, v9 row_shl:4 row_mask:0xf bank_mask:0xf bound_ctrl:0
    v_and_b32 v18, v2, v10
    v_and_b32 v19, v2, v11
    s_waitcnt vmcnt(15)
    v_mfma_f32_16x16x32_bf16 v[28:31], a[48:51], v[12:15], v[28:31]
    buffer_load_dwordx4 a[48:51], v44, s[8:11], s24 offen offset:0 nt
    s_waitcnt vmcnt(15)
    v_mfma_f32_16x16x32_bf16 v[28:31], a[52:55], v[16:19], v[28:31]
    buffer_load_dwordx4 a[52:55], v44, s[8:11], s24 offen offset:1024 nt
    s_waitcnt vmcnt(15)
    v_mfma_f32_16x16x32_bf16 v[32:35], a[56:59], v[12:15], v[32:35]
    buffer_load_dwordx4 a[56:59], v44, s[8:11], s24 offen offset:2048 nt
    s_waitcnt vmcnt(15)
    v_mfma_f32_16x16x32_bf16 v[32:35], a[60:63], v[16:19], v[32:35]
    buffer_load_dwordx4 a[60:63], v44, s[8:11], s24 offen offset:3072 nt
    s_or_b32 s24, s24, 0x10000
    s_add_u32 s24, s24, 4096
    s_and_b32 s24, s24, 0x6f000
    s_branch L_vtail
L_vfast:
    s_set_gpr_idx_on s37, gpr_idx(SRC0)
    v_fma_f32 v48, v52, s26, -v4
    v_fma_f32 v49, v53, s26, -v4
    v_fma_f32 v50, v54, s26, -v4
    v_fma_f32 v51, v55, s26, -v4
    s_set_gpr_idx_off
    v_exp_f32 v48, v48
    v_exp_f32 v49, v49
    v_exp_f32 v50, v50
    v_exp_f32 v51, v51
    v_cvt_pk_bf16_f32 v2, v48, v48
    v_add_f32 v5, v5, v48
    v_and_b32 v12, v2, v8
    v_and_b32 v13, v2, v9
    v_and_b32_dpp v14, v2, v10 row_shr:4 row_mask:0xf bank_mask:0xf bound_ctrl:0
    v_and_b32_dpp v15, v2, v11 row_shr:4 row_mask:0xf bank_mask:0xf bound_ctrl:0
    v_and_b32_dpp v16, v2, v8 row_shl:4 row_mask:0xf bank_mask:0xf bound_ctrl:0
    v_and_b32_dpp v17, v2, v9 row_shl:4 row_mask:0xf bank_mask:0xf bound_ctrl:0
    v_and_b32 v18, v2, v10
    v_and_b32 v19, v2, v11
    s_waitcnt vmcnt(12)
    v_mfma_f32_16x16x32_bf16 v[28:31], a[0:3], v[12:15], v[28:31]
    buffer_load_dwordx4 a[0:3], v44, s[8:11], s24 offen offset:0 nt
    s_waitcnt vmcnt(12)
    v_mfma_f32_16x16x32_bf16 v[28:31], a[4:7], v[16:19], v[28:31]
    buffer_load_dwordx4 a[4:7], v44, s[8:11], s24 offen offset:1024 nt
    s_waitcnt vmcnt(12)
    v_mfma_f32_16x16x32_bf16 v[32:35], a[8:11], v[12:15], v[32:35]
    buffer_load_dwordx4 a[8:11], v44, s[8:11], s24 offen offset:2048 nt
    s_waitcnt vmcnt(12)
    v_mfma_f32_16x16x32_bf16 v[32:35], a[12:15], v[16:19], v[32:35]
    buffer_load_dwordx4 a[12:15], v44, s[8:11], s24 offen offset:3072 nt
    s_or_b32 s24, s24, 0x10000
    s_add_u32 s24, s24, 4096
    s_and_b32 s24, s24, 0x6f000
    v_cvt_pk_bf16_f32 v2, v49, v49
    v_add_f32 v5, v5, v49
    v_and_b32 v12, v2, v8
    v_and_b32 v13, v2, v9
    v_and_b32_dpp v14, v2, v10 row_shr:4 row_mask:0xf bank_mask:0xf bound_ctrl:0
    v_and_b32_dpp v15, v2, v11 row_shr:4 row_mask:0xf bank_mask:0xf bound_ctrl:0
    v_and_b32_dpp v16, v2, v8 row_shl:4 row_mask:0xf bank_mask:0xf bound_ctrl:0
    v_and_b32_dpp v17, v2, v9 row_shl:4 row_mask:0xf bank_mask:0xf bound_ctrl:0
    v_and_b32 v18, v2, v10
    v_and_b32 v19, v2, v11
    s_waitcnt vmcnt(12)
    v_mfma_f32_16x16x32_bf16 v[28:31], a[16:19], v[12:15], v[28:31]
    buffer_load_dwordx4 a[16:19], v44, s[8:11], s24 offen offset:0 nt
    s_waitcnt vmcnt(12)
    v_mfma_f32_16x16x32_bf16 v[28:31], a[20:23], v[16:19], v[28:31]
    buffer_load_dwordx4 a[20:23], v44, s[8:11], s24 offen offset:1024 nt
    s_waitcnt vmcnt(12)
    v_mfma_f32_16x16x32_bf16 v[32:35], a[24:27], v[12:15], v[32:35]
    buffer_load_dwordx4 a[24:27], v44, s[8:11], s24 offen offset:2048 nt
    s_waitcnt vmcnt(12)
    v_mfma_f32_16x16x32_bf16 v[32:35], a[28:31], v[16:19], v[32:35]
    buffer_load_dwordx4 a[28:31], v44, s[8:11], s24 offen offset:3072 nt
    s_or_b32 s24, s24, 0x10000
    s_add_u32 s24, s24, 4096
    s_and_b32 s24, s24, 0x6f000
    v_cvt_pk_bf16_f32 v2, v50, v50
    v_add_f32 v5, v5, v50
    v_and_b32 v12, v2, v8
    v_and_b32 v13, v2, v9
    v_and_b32_dpp v14, v2, v10 row_shr:4 row_mask:0xf bank_mask:0xf bound_ctrl:0
    v_and_b32_dpp v15, v2, v11 row_shr:4 row_mask:0xf bank_mask:0xf bound_ctrl:0
    v_and_b32_dpp v16, v2, v8 row_shl:4 row_mask:0xf bank_mask:0xf bound_ctrl:0
    v_and_b32_dpp v17, v2, v9 row_shl:4 row_mask:0xf bank_mask:0xf bound_ctrl:0
    v_and_b32 v18, v2, v10
    v_and_b32 v19, v2, v11
    s_waitcnt vmcnt(12)
    v_mfma_f32_16x16x32_bf16 v[28:31], a[32:35], v[12:15], v[28:31]
    buffer_load_dwordx4 a[32:35], v44, s[8:11], s24 offen offset:0 nt
    s_waitcnt vmcnt(12)
    v_mfma_f32_16x16x32_bf16 v[28:31], a[36:39], v[16:19], v[28:31]
    buffer_load_dwordx4 a[36:39], v44, s[8:11], s24 offen offset:1024 nt
    s_waitcnt vmcnt(12)
    v_mfma_f32_16x16x32_bf16 v[32:35], a[40:43], v[12:15], v[32:35]
    buffer_load_dwordx4 a[40:43], v44, s[8:11], s24 offen offset:2048 nt
    s_waitcnt vmcnt(12)
    v_mfma_f32_16x16x32_bf16 v[32:35], a[44:47], v[16:19], v[32:35]
    buffer_load_dwordx4 a[44:47], v44, s[8:11], s24 offen offset:3072 nt
    s_or_b32 s24, s24, 0x10000
    s_add_u32 s24, s24, 4096
    s_and_b32 s24, s24, 0x6f000
    v_cvt_pk_bf16_f32 v2, v51, v51
    v_add_f32 v5, v5, v51
    v_and_b32 v12, v2, v8
    v_and_b32 v13, v2, v9
    v_and_b32_dpp v14, v2, v10 row_shr:4 row_mask:0xf bank_mask:0xf bound_ctrl:0
    v_and_b32_dpp v15, v2, v11 row_shr:4 row_mask:0xf bank_mask:0xf bound_ctrl:0
    v_and_b32_dpp v16, v2, v8 row_shl:4 row_mask:0xf bank_mask:0xf bound_ctrl:0
    v_and_b32_dpp v17, v2, v9 row_shl:4 row_mask:0xf bank_mask:0xf bound_ctrl:0
    v_and_b32 v18, v2, v10
    v_and_b32 v19, v2, v11
    s_waitcnt vmcnt(10)
    v_mfma_f32_16x16x32_bf16 v[28:31], a[48:51], v[12:15], v[28:31]
    buffer_load_dwordx4 a[48:51], v44, s[8:11], s24 offen offset:0 nt
    s_waitcnt vmcnt(10)
    v_mfma_f32_16x16x32_bf16 v[28:31], a[52:55], v[16:19], v[28:31]
    buffer_load_dwordx4 a[52:55], v44, s[8:11], s24 offen offset:1024 nt
    s_waitcnt vmcnt(10)
    v_mfma_f32_16x16x32_bf16 v[32:35], a[56:59], v[12:15], v[32:35]
    buffer_load_dwordx4 a[56:59], v44, s[8:11], s24 offen offset:2048 nt
    s_waitcnt vmcnt(10)
    v_mfma_f32_16x16x32_bf16 v[32:35], a[60:63], v[16:19], v[32:35]
    buffer_load_dwordx4 a[60:63], v44, s[8:11], s24 offen offset:3072 nt
    s_or_b32 s24, s24, 0x10000
    s_add_u32 s24, s24, 4096
    s_and_b32 s24, s24, 0x6f000
L_vtail:
    s_cmp_ge_u32 s36, 60
    s_cbranch_scc1 L_v_nofb
    v_sad_u8 v42, v43, 0, 0
    s_add_u32 s84, s36, 1
    v_msad_u8 v47, -1, v43, v42
    v_lshl_add_u32 v42, v47, 16, v42
    v_mov_b32 v47, s84
    s_lshl_b32 s84, s36, 5
    v_add_u32_dpp v42, v42, v42 quad_perm:[1,0,3,2] row_mask:0xf bank_mask:0xf
    s_sub_u32 s84, s84, 14
    s_nop 0
    v_add_u32_dpp v42, v42, v42 quad_perm:[2,3,0,1] row_mask:0xf bank_mask:0xf
    s_nop 1
    v_add_u32_dpp v42, v42, v42 row_ror:4 row_mask:0xf bank_mask:0xf
    s_mov_b64 exec, 1
    v_readfirstlane_b32 s81, v42
    global_store_byte v46, v47, s[70:71]
    s_mov_b64 exec, -1
    global_load_dword v43, v45, s[70:71] sc0
    s_lshr_b32 s87, s81, 16
    s_and_b32 s81, s81, 0xffff
    s_mul_i32 s84, s84, s87
    s_mul_i32 s81, s81, 255 * 32
    s_sub_i32 s84, s81, s84
    s_ashr_i32 s84, s84, 8
    s_mul_i32 s84, s84, 32
    s_ashr_i32 s84, s84, 8
    s_add_i32 s84, s84, s86
    s_max_i32 s84, s84, 0
    s_min_i32 s82, s84, 128
L_v_nofb:
    s_add_u32 s40, s36, 2
    s_add_u32 s36, s36, 1
    s_add_u32 s37, s37, 4
    s_and_b32 s40, s40, 14
    s_cbranch_scc1 L_v
    s_bitcmp1_b32 s36, 0
    s_cbranch_scc0 L_vdone
    s_cmp_gt_u32 s36, 48
    s_cselect_b32 s10, 0, s10
    s_mov_b32 s8, s62
    s_mov_b32 s9, s63
    s_mov_b32 s24, s43
    s_branch L_v
L_vdone:
    s_lshr_b32 s38, s36, 6
    v_add_f32_dpp v5, v5, v5 row_ror:4 row_mask:0xf bank_mask:0xf
    v_lshrrev_b32 v3, 4, v0
    v_and_b32 v6, 7, v0
    v_add_f32_dpp v5, v5, v5 row_ror:8 row_mask:0xf bank_mask:0xf
    v_lshlrev_b32 v3, 7, v3
    v_mov_b32 v2, v5
    v_lshl_add_u32 v3, v6, 2, v3
    s_nop 0
    v_permlane16_swap_b32 v2, v5
    v_add_f32_dpp v28, v32, v28 row_ror:8 row_mask:0xf bank_mask:0xf
    v_add_f32_dpp v29, v33, v29 row_ror:8 row_mask:0xf bank_mask:0xf
    v_add_f32 v5, v5, v2
    v_mov_b32 v2, v5
    v_add_f32_dpp v30, v34, v30 row_ror:8 row_mask:0xf bank_mask:0xf
    v_add_f32_dpp v31, v35, v31 row_ror:8 row_mask:0xf bank_mask:0xf
    v_permlane32_swap_b32 v2, v5
    s_nop 1
    v_add_f32 v5, v5, v2
    s_mul_i32 s40, s38, 2
    s_add_u32 s40, s40, s25
    s_lshl_b32 s35, s40, 9
    s_lshl_b32 s40, s40, 3
    v_add_u32 v3, s35, v3
    v_mov_b32 v6, s40
    s_mov_b32 exec_lo, 0x00ff00ff
    s_mov_b32 exec_hi, 0x00ff00ff
    ds_write_b32 v3, v28 offset:0
    ds_write_b32 v3, v29 offset:32
    ds_write_b32 v3, v30 offset:64
    ds_write_b32 v3, v31 offset:96
    ds_write_b64 v6, v[4:5] offset:2048
    s_mov_b64 exec, -1
    s_cmp_lg_u32 s38, 0
    s_cbranch_scc1 L_fin
    v_mov_b32 v4, v39
    s_branch L_vinit
L_fin:
    s_waitcnt lgkmcnt(0)
    s_barrier
    s_mul_i32 s40, s25, 16
    s_mul_i32 s35, s25, 1024
    v_mov_b32 v2, s40
    v_lshl_add_u32 v3, v0, 3, s35
    ds_read_b128 v[52:55], v2 offset:2048
    ds_read_b64 v[56:57], v3 offset:0
    ds_read_b64 v[58:59], v3 offset:512
    s_cmp_eq_u32 s25, 0
    s_cselect_b32 s3, s3, s34
    s_waitcnt lgkmcnt(2)
    v_max_f32 v4, v52, v54
    v_sub_f32 v52, v52, v4
    v_sub_f32 v54, v54, v4
    v_exp_f32 v52, v52
    v_exp_f32 v54, v54
    s_nop 0
    v_mul_f32 v5, v52, v53
    v_fmac_f32 v5, v54, v55
    v_rcp_f32 v5, v5
    s_waitcnt lgkmcnt(0)
    v_mul_f32 v28, v52, v56
    v_mul_f32 v29, v52, v57
    v_fmac_f32 v28, v54, v58
    v_fmac_f32 v29, v54, v59
    v_mul_f32 v28, v28, v5
    v_mul_f32 v29, v29, v5
    v_lshlrev_b32 v3, 2, v0
    v_cvt_pk_bf16_f32 v28, v28, v29
    buffer_store_dword v28, v3, s[20:23], s3 offen
L_done:
    s_endpgm
.section .rodata,"a"
.p2align 6
.amdhsa_kernel standalone__softmax_full_bidir__sampling_kernel
  .amdhsa_next_free_vgpr 244
  .amdhsa_next_free_sgpr 88
  .amdhsa_accum_offset 180
  .amdhsa_group_segment_fixed_size 0
  .amdhsa_kernarg_size 48
  .amdhsa_user_sgpr_count 2
  .amdhsa_user_sgpr_kernarg_segment_ptr 1
  .amdhsa_system_sgpr_workgroup_id_x 1
.end_amdhsa_kernel
```
